```python
import torch

def _softmax(x, axis=-1):
    return torch.softmax(x, dim=axis)
def _gelu(x):
    return torch.nn.functional.gelu(x, approximate="tanh")
def _silu(x):
    return torch.nn.functional.silu(x)
def _sigmoid(x):
    return torch.sigmoid(x)
def _layernorm(x, axis=-1, eps=1e-5):
    m = x.mean(dim=axis, keepdim=True)
    v = x.var(dim=axis, keepdim=True, unbiased=False)
    return (x - m) / torch.sqrt(v + eps)
def _scatter_add(tgt, idx, src, axis=0):
    return tgt.clone().index_add_(axis, idx, src)
def _segment_sum(src, seg, n):
    out = torch.zeros((n,) + src.shape[1:], dtype=src.dtype)
    return out.index_add_(0, seg, src)
def _pad(x, pw):
    flat = tuple(v for pair in reversed(pw) for v in pair)
    return torch.nn.functional.pad(x, flat)

kernel_name = 'standalone__gqa_softmax__sampling'

def setup_inputs():

    _w = (lambda a: (lambda t: t.to(torch.bfloat16) if t.is_floating_point() else t)(torch.as_tensor(a)))
    B, Hq, Hkv, Sq, Sk, D = 8, 32, 8, 1, 2048, 128
    return {
        "q": _w((lambda *s: torch.randn(*s, dtype=torch.bfloat16) * 0.8)(B, Hq, Sq, D)),
        "k": _w((lambda *s: torch.randn(*s, dtype=torch.bfloat16) * 0.8)(B, Hkv, Sk, D)),
        "v": _w((lambda *s: torch.randn(*s, dtype=torch.bfloat16) * 0.05)(B, Hkv, Sk, D)),
    }

def reference(q, k, v):
    B, Hq, Sq, D = q.shape
    Hkv = k.shape[1]
    rep = Hq // Hkv
    k = (lambda x, n, axis: torch.repeat_interleave(x, n, dim=axis))(k, rep, axis=1)
    v = (lambda x, n, axis: torch.repeat_interleave(x, n, dim=axis))(v, rep, axis=1)
    scale = D ** -0.5
    scores = torch.einsum("bhqd,bhkd->bhqk", q, k) * scale
    p = _softmax(scores, axis=-1)
    return torch.einsum("bhqk,bhkd->bhqd", p, v)
```

```asm
; @launch grid=(256,1,1) block=(512,1,1) lds=18944
.amdgcn_target "amdgcn-amd-amdhsa--gfx950"
.text
.globl standalone__gqa_softmax__sampling_kernel
.p2align 8
.type standalone__gqa_softmax__sampling_kernel,@function
standalone__gqa_softmax__sampling_kernel:
    s_load_dwordx2 s[8:9], s[0:1], 8
    s_load_dwordx2 s[4:5], s[0:1], 0
    s_load_dwordx2 s[12:13], s[0:1], 16
    s_load_dwordx2 s[20:21], s[0:1], 40
    s_load_dwordx2 s[24:25], s[0:1], 32
    s_load_dwordx2 s[16:17], s[0:1], 24
    s_cmp_ge_u32 s2, 256
    s_cbranch_scc1 L_end
    v_readfirstlane_b32 s28, v0
    v_and_b32 v0, 63, v0
    s_and_b32 s29, s2, 7
    s_lshr_b32 s30, s2, 3
    s_mov_b32 s6, 65536
    s_mov_b32 s7, 0x20000
    s_mov_b32 s11, 0x20000
    s_mov_b32 s15, 0x20000
    s_lshr_b32 s28, s28, 6
    s_lshl_b32 s31, s29, 3
    s_lshr_b32 s54, s30, 2
    s_add_u32 s31, s31, s54
    s_and_b32 s48, s30, 3
    s_lshl_b32 s53, s48, 6
    s_cmp_eq_u32 s48, 3
    s_cselect_b32 s51, 1, 0
    s_lshl_b32 s54, s28, 3
    s_add_u32 s54, s54, s53
    s_lshl_b32 s55, s31, 8
    s_add_u32 s54, s54, s55
    s_bfe_u32 s55, s54, 0x30005
    s_or_b32 s54, s54, s55
    s_lshl_b32 s32, s54, 11
    s_xor_b32 s33, s32, 2048
    s_xor_b32 s34, s32, 4096
    s_xor_b32 s35, s32, 6144
    s_xor_b32 s36, s32, 8192
    s_xor_b32 s37, s32, 10240
    s_xor_b32 s38, s32, 12288
    s_xor_b32 s39, s32, 14336
    s_lshl_b32 s44, s31, 10
    v_lshrrev_b32 v14, 4, v0
    v_bfe_u32 v15, v0, 2, 2
    v_and_b32 v16, 1, v0
    v_lshlrev_b32 v14, 5, v14
    v_lshlrev_b32 v16, 4, v16
    v_lshl_add_u32 v3, v15, 8, v14
    v_bfe_u32 v17, v0, 1, 1
    v_add_u32 v3, v3, v16
    v_lshlrev_b32 v2, 4, v0
    v_lshl_add_u32 v1, v17, 10, v3
    s_mov_b32 s22, 0x100000
    s_mov_b32 s23, 0x20000
    s_mov_b32 s26, 256
    s_mov_b32 s27, 0x20000
    s_lshl_b32 s56, s31, 14
    s_lshl_b32 s55, s48, 11
    s_add_u32 s57, s56, 2048
    s_add_u32 s58, s56, 4096
    s_add_u32 s49, s56, s55
    s_lshl_b32 s47, s31, 2
    s_getreg_b32 s63, hwreg(HW_REG_XCC_ID, 0, 4)
    s_cmp_eq_u32 s28, 7
    s_cselect_b32 s62, 2, 0
    s_cmp_eq_u32 s28, 3
    s_cselect_b32 s59, 1, 0
    s_add_u32 s63, s63, 1
    s_cmp_eq_u32 s51, 0
    s_cselect_b32 s62, s62, s59
    s_cmp_lg_u32 s62, 1
    s_waitcnt lgkmcnt(0)
    s_cbranch_scc1 L_go
    v_mov_b32 v36, -1
    v_mov_b32 v37, -1
    v_mov_b32 v38, -1
    v_mov_b32 v39, -1
    buffer_store_dwordx4 v[36:39], v2, s[20:23], s56 offen offset:0
    buffer_store_dwordx4 v[36:39], v2, s[20:23], s56 offen offset:1024
    buffer_store_dwordx4 v[36:39], v2, s[20:23], s56 offen offset:2048
    buffer_store_dwordx4 v[36:39], v2, s[20:23], s56 offen offset:3072
    buffer_store_dwordx4 v[36:39], v2, s[20:23], s58 offen offset:0
    buffer_store_dwordx4 v[36:39], v2, s[20:23], s58 offen offset:1024
L_go:
    buffer_load_dwordx4 v[20:23], v3, s[4:7], s44 offen offset:0
    buffer_load_dwordx4 v[24:27], v3, s[4:7], s44 offen offset:128
    s_mov_b32 s10, 0x2000000
    buffer_load_dwordx4 v[64:67], v1, s[8:11], s32 offen offset:0 nt
    buffer_load_dwordx4 v[68:71], v1, s[8:11], s32 offen offset:128 nt
    buffer_load_dwordx4 v[72:75], v1, s[8:11], s33 offen offset:0 nt
    buffer_load_dwordx4 v[76:79], v1, s[8:11], s33 offen offset:128 nt
    buffer_load_dwordx4 v[80:83], v1, s[8:11], s34 offen offset:0 nt
    buffer_load_dwordx4 v[84:87], v1, s[8:11], s34 offen offset:128 nt
    buffer_load_dwordx4 v[88:91], v1, s[8:11], s35 offen offset:0 nt
    buffer_load_dwordx4 v[92:95], v1, s[8:11], s35 offen offset:128 nt
    buffer_load_dwordx4 v[96:99], v1, s[8:11], s36 offen offset:0 nt
    buffer_load_dwordx4 v[100:103], v1, s[8:11], s36 offen offset:128 nt
    buffer_load_dwordx4 v[104:107], v1, s[8:11], s37 offen offset:0 nt
    buffer_load_dwordx4 v[108:111], v1, s[8:11], s37 offen offset:128 nt
    buffer_load_dwordx4 v[112:115], v1, s[8:11], s38 offen offset:0 nt
    buffer_load_dwordx4 v[116:119], v1, s[8:11], s38 offen offset:128 nt
    buffer_load_dwordx4 v[120:123], v1, s[8:11], s39 offen offset:0 nt
    buffer_load_dwordx4 v[124:127], v1, s[8:11], s39 offen offset:128 nt
    s_mov_b32 s14, 0x2000000
    buffer_load_dwordx4 v[128:131], v2, s[12:15], s32 offen offset:0 nt
    buffer_load_dwordx4 v[132:135], v2, s[12:15], s32 offen offset:1024 nt
    buffer_load_dwordx4 v[136:139], v2, s[12:15], s33 offen offset:0 nt
    buffer_load_dwordx4 v[140:143], v2, s[12:15], s33 offen offset:1024 nt
    buffer_load_dwordx4 v[144:147], v2, s[12:15], s34 offen offset:0 nt
    buffer_load_dwordx4 v[148:151], v2, s[12:15], s34 offen offset:1024 nt
    buffer_load_dwordx4 v[152:155], v2, s[12:15], s35 offen offset:0 nt
    buffer_load_dwordx4 v[156:159], v2, s[12:15], s35 offen offset:1024 nt
    buffer_load_dwordx4 v[160:163], v2, s[12:15], s36 offen offset:0 nt
    buffer_load_dwordx4 v[164:167], v2, s[12:15], s36 offen offset:1024 nt
    buffer_load_dwordx4 v[168:171], v2, s[12:15], s37 offen offset:0 nt
    buffer_load_dwordx4 v[172:175], v2, s[12:15], s37 offen offset:1024 nt
    buffer_load_dwordx4 v[176:179], v2, s[12:15], s38 offen offset:0 nt
    buffer_load_dwordx4 v[180:183], v2, s[12:15], s38 offen offset:1024 nt
    buffer_load_dwordx4 v[184:187], v2, s[12:15], s39 offen offset:0 nt
    buffer_load_dwordx4 v[188:191], v2, s[12:15], s39 offen offset:1024 nt
    s_mov_b32 s18, 65536
    s_mov_b32 s19, 0x20000
    s_mov_b32 s46, 0x3e0293ee
    s_mov_b32 s55, 0xffff
    s_mov_b32 vcc_lo, 0xaaaaaaaa
    s_mov_b32 vcc_hi, 0xaaaaaaaa
    s_mov_b32 s60, 0x100000
    v_mov_b32 v6, s46
    v_lshlrev_b32 v18, v16, s55
    v_bfe_i32 v19, v0, 1, 1
    v_and_b32 v5, v18, v19
    v_xor_b32 v4, v18, v5
    s_mul_i32 s55, s28, 2304
    v_add_u32 v7, s55, v2
    s_lshl_b32 s55, s28, 3
    s_add_u32 s55, s55, 18432
    v_lshlrev_b32 v8, 6, v15
    v_add_u32 v8, s55, v8
    s_lshl_b32 s55, s28, 7
    v_bfe_u32 v14, v0, 2, 3
    v_and_b32 v18, 1, v0
    v_bfe_u32 v19, v0, 1, 1
    v_lshlrev_b32 v14, 4, v14
    v_mul_u32_u24 v19, 1152, v19
    v_lshl_add_u32 v14, v18, 3, v14
    v_lshrrev_b32 v18, 5, v0
    v_add3_u32 v9, v14, v19, s55
    v_mul_u32_u24 v19, 9216, v18
    v_and_b32 v14, 31, v0
    v_add_u32 v9, v9, v19
    v_lshl_add_u32 v14, v14, 1, v18
    v_lshl_add_u32 v12, v14, 1, s55
    v_lshl_add_u32 v11, v0, 1, s55
    v_lshlrev_b32 v11, 1, v11
    s_lshr_b32 s55, s28, 1
    s_lshl_b32 s55, s55, 6
    s_add_u32 s55, s55, 18432
    v_lshl_add_u32 v14, v18, 2, v0
    v_and_b32 v14, 7, v14
    v_lshl_add_u32 v10, v14, 3, s55
    s_waitcnt vmcnt(31)
    s_cmp_eq_u32 s62, 0
    s_cbranch_scc0 L_side
L_sback:
    v_mfma_f32_16x16x32_bf16 v[28:31], v[64:67], v[20:23], 0
    s_waitcnt vmcnt(30)
    v_mfma_f32_16x16x32_bf16 v[28:31], v[68:71], v[24:27], v[28:31]
    s_waitcnt vmcnt(29)
    v_mfma_f32_16x16x32_bf16 v[32:35], v[72:75], v[20:23], 0
    s_waitcnt vmcnt(28)
    v_mfma_f32_16x16x32_bf16 v[32:35], v[76:79], v[24:27], v[32:35]
    s_waitcnt vmcnt(27)
    v_mfma_f32_16x16x32_bf16 v[64:67], v[80:83], v[20:23], 0
    s_waitcnt vmcnt(26)
    v_mfma_f32_16x16x32_bf16 v[64:67], v[84:87], v[24:27], v[64:67]
    s_nop 0
    v_add_f32_dpp v44, v29, v28 quad_perm:[1,1,3,3] row_mask:0xf bank_mask:0xf
    v_add_f32_dpp v45, v31, v30 quad_perm:[1,1,3,3] row_mask:0xf bank_mask:0xf
    v_max_f32 v14, v44, v45
    s_waitcnt vmcnt(25)
    v_mfma_f32_16x16x32_bf16 v[72:75], v[88:91], v[20:23], 0
    s_waitcnt vmcnt(24)
    v_mfma_f32_16x16x32_bf16 v[72:75], v[92:95], v[24:27], v[72:75]
    v_add_f32_dpp v46, v33, v32 quad_perm:[1,1,3,3] row_mask:0xf bank_mask:0xf
    v_add_f32_dpp v47, v35, v34 quad_perm:[1,1,3,3] row_mask:0xf bank_mask:0xf
    v_max3_f32 v14, v14, v46, v47
    s_waitcnt vmcnt(23)
    v_mfma_f32_16x16x32_bf16 v[80:83], v[96:99], v[20:23], 0
    s_waitcnt vmcnt(22)
    v_mfma_f32_16x16x32_bf16 v[80:83], v[100:103], v[24:27], v[80:83]
    v_add_f32_dpp v48, v65, v64 quad_perm:[1,1,3,3] row_mask:0xf bank_mask:0xf
    v_add_f32_dpp v49, v67, v66 quad_perm:[1,1,3,3] row_mask:0xf bank_mask:0xf
    v_max3_f32 v14, v14, v48, v49
    s_waitcnt vmcnt(21)
    v_mfma_f32_16x16x32_bf16 v[88:91], v[104:107], v[20:23], 0
    s_waitcnt vmcnt(20)
    v_mfma_f32_16x16x32_bf16 v[88:91], v[108:111], v[24:27], v[88:91]
    v_add_f32_dpp v50, v73, v72 quad_perm:[1,1,3,3] row_mask:0xf bank_mask:0xf
    v_add_f32_dpp v51, v75, v74 quad_perm:[1,1,3,3] row_mask:0xf bank_mask:0xf
    v_max3_f32 v14, v14, v50, v51
    s_waitcnt vmcnt(19)
    v_mfma_f32_16x16x32_bf16 v[96:99], v[112:115], v[20:23], 0
    s_waitcnt vmcnt(18)
    v_mfma_f32_16x16x32_bf16 v[96:99], v[116:119], v[24:27], v[96:99]
    v_add_f32_dpp v52, v81, v80 quad_perm:[1,1,3,3] row_mask:0xf bank_mask:0xf
    v_add_f32_dpp v53, v83, v82 quad_perm:[1,1,3,3] row_mask:0xf bank_mask:0xf
    v_max3_f32 v14, v14, v52, v53
    s_waitcnt vmcnt(17)
    v_mfma_f32_16x16x32_bf16 v[104:107], v[120:123], v[20:23], 0
    s_waitcnt vmcnt(16)
    v_mfma_f32_16x16x32_bf16 v[104:107], v[124:127], v[24:27], v[104:107]
    v_add_f32_dpp v54, v89, v88 quad_perm:[1,1,3,3] row_mask:0xf bank_mask:0xf
    v_add_f32_dpp v55, v91, v90 quad_perm:[1,1,3,3] row_mask:0xf bank_mask:0xf
    v_max3_f32 v14, v14, v54, v55
    s_nop 0
    v_add_f32_dpp v56, v97, v96 quad_perm:[1,1,3,3] row_mask:0xf bank_mask:0xf
    v_add_f32_dpp v57, v99, v98 quad_perm:[1,1,3,3] row_mask:0xf bank_mask:0xf
    v_max3_f32 v14, v14, v56, v57
    s_nop 0
    v_add_f32_dpp v58, v105, v104 quad_perm:[1,1,3,3] row_mask:0xf bank_mask:0xf
    v_add_f32_dpp v59, v107, v106 quad_perm:[1,1,3,3] row_mask:0xf bank_mask:0xf
    v_max3_f32 v14, v14, v58, v59
    v_mov_b32 v15, v14
    s_nop 1
    v_permlane16_swap_b32 v14, v15
    v_max_f32 v14, v14, v15
    v_mov_b32 v15, v14
    s_nop 1
    v_permlane32_swap_b32 v14, v15
    v_max_f32 v14, v14, v15
    s_nop 1
    v_mul_f32_dpp v16, v14, v6 quad_perm:[0,0,2,2] row_mask:0xf bank_mask:0xf
    v_pk_fma_f32 v[44:45], v[44:45], s[46:47], v[16:17] op_sel_hi:[1,0,0] neg_lo:[0,0,1] neg_hi:[0,0,1]
    v_pk_fma_f32 v[46:47], v[46:47], s[46:47], v[16:17] op_sel_hi:[1,0,0] neg_lo:[0,0,1] neg_hi:[0,0,1]
    v_pk_fma_f32 v[48:49], v[48:49], s[46:47], v[16:17] op_sel_hi:[1,0,0] neg_lo:[0,0,1] neg_hi:[0,0,1]
    v_pk_fma_f32 v[50:51], v[50:51], s[46:47], v[16:17] op_sel_hi:[1,0,0] neg_lo:[0,0,1] neg_hi:[0,0,1]
    v_pk_fma_f32 v[52:53], v[52:53], s[46:47], v[16:17] op_sel_hi:[1,0,0] neg_lo:[0,0,1] neg_hi:[0,0,1]
    v_pk_fma_f32 v[54:55], v[54:55], s[46:47], v[16:17] op_sel_hi:[1,0,0] neg_lo:[0,0,1] neg_hi:[0,0,1]
    v_pk_fma_f32 v[56:57], v[56:57], s[46:47], v[16:17] op_sel_hi:[1,0,0] neg_lo:[0,0,1] neg_hi:[0,0,1]
    v_pk_fma_f32 v[58:59], v[58:59], s[46:47], v[16:17] op_sel_hi:[1,0,0] neg_lo:[0,0,1] neg_hi:[0,0,1]
    v_exp_f32_dpp v44, v44 quad_perm:[0,0,2,2] row_mask:0xf bank_mask:0xf
    v_exp_f32_dpp v45, v45 quad_perm:[0,0,2,2] row_mask:0xf bank_mask:0xf
    v_exp_f32_dpp v46, v46 quad_perm:[0,0,2,2] row_mask:0xf bank_mask:0xf
    v_exp_f32_dpp v47, v47 quad_perm:[0,0,2,2] row_mask:0xf bank_mask:0xf
    v_exp_f32_dpp v48, v48 quad_perm:[0,0,2,2] row_mask:0xf bank_mask:0xf
    v_exp_f32_dpp v49, v49 quad_perm:[0,0,2,2] row_mask:0xf bank_mask:0xf
    v_exp_f32_dpp v50, v50 quad_perm:[0,0,2,2] row_mask:0xf bank_mask:0xf
    v_exp_f32_dpp v51, v51 quad_perm:[0,0,2,2] row_mask:0xf bank_mask:0xf
    v_exp_f32_dpp v52, v52 quad_perm:[0,0,2,2] row_mask:0xf bank_mask:0xf
    v_exp_f32_dpp v53, v53 quad_perm:[0,0,2,2] row_mask:0xf bank_mask:0xf
    v_exp_f32_dpp v54, v54 quad_perm:[0,0,2,2] row_mask:0xf bank_mask:0xf
    v_exp_f32_dpp v55, v55 quad_perm:[0,0,2,2] row_mask:0xf bank_mask:0xf
    v_exp_f32_dpp v56, v56 quad_perm:[0,0,2,2] row_mask:0xf bank_mask:0xf
    v_exp_f32_dpp v57, v57 quad_perm:[0,0,2,2] row_mask:0xf bank_mask:0xf
    v_exp_f32_dpp v58, v58 quad_perm:[0,0,2,2] row_mask:0xf bank_mask:0xf
    v_exp_f32_dpp v59, v59 quad_perm:[0,0,2,2] row_mask:0xf bank_mask:0xf
    v_cvt_pk_bf16_f32 v96, v44, v44
    v_cvt_pk_bf16_f32 v97, v45, v45
    v_cvt_pk_bf16_f32 v98, v46, v46
    v_cvt_pk_bf16_f32 v99, v47, v47
    v_cvt_pk_bf16_f32 v100, v48, v48
    v_cvt_pk_bf16_f32 v101, v49, v49
    v_cvt_pk_bf16_f32 v102, v50, v50
    v_cvt_pk_bf16_f32 v103, v51, v51
    v_cvt_pk_bf16_f32 v104, v52, v52
    v_cvt_pk_bf16_f32 v105, v53, v53
    v_cvt_pk_bf16_f32 v106, v54, v54
    v_cvt_pk_bf16_f32 v107, v55, v55
    v_cvt_pk_bf16_f32 v108, v56, v56
    v_cvt_pk_bf16_f32 v109, v57, v57
    v_cvt_pk_bf16_f32 v110, v58, v58
    v_cvt_pk_bf16_f32 v111, v59, v59
    v_and_b32 v64, v4, v96
    v_and_b32 v65, v5, v96
    v_and_b32 v66, v4, v97
    v_and_b32 v67, v5, v97
    v_and_b32 v68, v4, v98
    v_and_b32 v69, v5, v98
    v_and_b32 v70, v4, v99
    v_and_b32 v71, v5, v99
    v_and_b32 v72, v4, v100
    v_and_b32 v73, v5, v100
    v_and_b32 v74, v4, v101
    v_and_b32 v75, v5, v101
    v_and_b32 v76, v4, v102
    v_and_b32 v77, v5, v102
    v_and_b32 v78, v4, v103
    v_and_b32 v79, v5, v103
    v_and_b32 v80, v4, v104
    v_and_b32 v81, v5, v104
    v_and_b32 v82, v4, v105
    v_and_b32 v83, v5, v105
    v_and_b32 v84, v4, v106
    v_and_b32 v85, v5, v106
    v_and_b32 v86, v4, v107
    v_and_b32 v87, v5, v107
    v_and_b32 v88, v4, v108
    v_and_b32 v89, v5, v108
    v_and_b32 v90, v4, v109
    v_and_b32 v91, v5, v109
    v_and_b32 v92, v4, v110
    v_and_b32 v93, v5, v110
    v_and_b32 v94, v4, v111
    v_and_b32 v95, v5, v111
    v_pk_add_f32 v[44:45], v[44:45], v[46:47]
    v_pk_add_f32 v[44:45], v[44:45], v[48:49]
    v_pk_add_f32 v[44:45], v[44:45], v[50:51]
    v_pk_add_f32 v[44:45], v[44:45], v[52:53]
    v_pk_add_f32 v[44:45], v[44:45], v[54:55]
    v_pk_add_f32 v[44:45], v[44:45], v[56:57]
    v_pk_add_f32 v[44:45], v[44:45], v[58:59]
    v_add_f32 v14, v44, v45
    v_mov_b32 v15, v14
    s_nop 1
    v_permlane16_swap_b32 v14, v15
    v_add_f32 v14, v14, v15
    v_mov_b32 v15, v14
    s_nop 1
    v_permlane32_swap_b32 v14, v15
    v_add_f32 v17, v14, v15
    ds_write_b64 v8, v[16:17]
    s_waitcnt vmcnt(15)
    v_mfma_f32_16x16x16_bf16 v[36:39], v[64:65], v[128:129], 0
    v_mfma_f32_16x16x16_bf16 v[40:43], v[64:65], v[130:131], 0
    s_waitcnt vmcnt(14)
    v_mfma_f32_16x16x16_bf16 v[36:39], v[66:67], v[132:133], v[36:39]
    v_mfma_f32_16x16x16_bf16 v[40:43], v[66:67], v[134:135], v[40:43]
    s_waitcnt vmcnt(13)
    v_mfma_f32_16x16x16_bf16 v[36:39], v[68:69], v[136:137], v[36:39]
    v_mfma_f32_16x16x16_bf16 v[40:43], v[68:69], v[138:139], v[40:43]
    s_waitcnt vmcnt(12)
    v_mfma_f32_16x16x16_bf16 v[36:39], v[70:71], v[140:141], v[36:39]
    v_mfma_f32_16x16x16_bf16 v[40:43], v[70:71], v[142:143], v[40:43]
    s_waitcnt vmcnt(11)
    v_mfma_f32_16x16x16_bf16 v[36:39], v[72:73], v[144:145], v[36:39]
    v_mfma_f32_16x16x16_bf16 v[40:43], v[72:73], v[146:147], v[40:43]
    s_waitcnt vmcnt(10)
    v_mfma_f32_16x16x16_bf16 v[36:39], v[74:75], v[148:149], v[36:39]
    v_mfma_f32_16x16x16_bf16 v[40:43], v[74:75], v[150:151], v[40:43]
    s_waitcnt vmcnt(9)
    v_mfma_f32_16x16x16_bf16 v[36:39], v[76:77], v[152:153], v[36:39]
    v_mfma_f32_16x16x16_bf16 v[40:43], v[76:77], v[154:155], v[40:43]
    s_waitcnt vmcnt(8)
    v_mfma_f32_16x16x16_bf16 v[36:39], v[78:79], v[156:157], v[36:39]
    v_mfma_f32_16x16x16_bf16 v[40:43], v[78:79], v[158:159], v[40:43]
    s_waitcnt vmcnt(7)
    v_mfma_f32_16x16x16_bf16 v[36:39], v[80:81], v[160:161], v[36:39]
    v_mfma_f32_16x16x16_bf16 v[40:43], v[80:81], v[162:163], v[40:43]
    s_waitcnt vmcnt(6)
    v_mfma_f32_16x16x16_bf16 v[36:39], v[82:83], v[164:165], v[36:39]
    v_mfma_f32_16x16x16_bf16 v[40:43], v[82:83], v[166:167], v[40:43]
    s_waitcnt vmcnt(5)
    v_mfma_f32_16x16x16_bf16 v[36:39], v[84:85], v[168:169], v[36:39]
    v_mfma_f32_16x16x16_bf16 v[40:43], v[84:85], v[170:171], v[40:43]
    s_waitcnt vmcnt(4)
    v_mfma_f32_16x16x16_bf16 v[36:39], v[86:87], v[172:173], v[36:39]
    v_mfma_f32_16x16x16_bf16 v[40:43], v[86:87], v[174:175], v[40:43]
    s_waitcnt vmcnt(3)
    v_mfma_f32_16x16x16_bf16 v[36:39], v[88:89], v[176:177], v[36:39]
    v_mfma_f32_16x16x16_bf16 v[40:43], v[88:89], v[178:179], v[40:43]
    s_waitcnt vmcnt(2)
    v_mfma_f32_16x16x16_bf16 v[36:39], v[90:91], v[180:181], v[36:39]
    v_mfma_f32_16x16x16_bf16 v[40:43], v[90:91], v[182:183], v[40:43]
    s_waitcnt vmcnt(1)
    v_mfma_f32_16x16x16_bf16 v[36:39], v[92:93], v[184:185], v[36:39]
    v_mfma_f32_16x16x16_bf16 v[40:43], v[92:93], v[186:187], v[40:43]
    s_waitcnt vmcnt(0)
    v_mfma_f32_16x16x16_bf16 v[36:39], v[94:95], v[188:189], v[36:39]
    v_mfma_f32_16x16x16_bf16 v[40:43], v[94:95], v[190:191], v[40:43]
    s_cmp_lg_u32 s62, 2
    s_nop 5
    ds_write_b128 v7, v[36:39]
    ds_write_b128 v7, v[40:43] offset:1152
    s_cbranch_scc0 L_role
    s_cmp_eq_u32 s51, 0
    s_cbranch_scc0 L_cons
L_back:
    s_waitcnt lgkmcnt(0)
    s_barrier
    ds_read_b64 v[128:129], v10
    ds_read_b64 v[130:131], v9 offset:0
    ds_read_b64 v[132:133], v9 offset:2304
    ds_read_b64 v[134:135], v9 offset:4608
    ds_read_b64 v[136:137], v9 offset:6912
    ds_read_b32 v13, v10 offset:256
    s_waitcnt lgkmcnt(5)
    v_max_f32_dpp v14, v128, v128 quad_perm:[1,0,3,2] row_mask:0xf bank_mask:0xf
    s_nop 1
    v_max_f32_dpp v14, v14, v14 quad_perm:[2,3,0,1] row_mask:0xf bank_mask:0xf
    s_nop 1
    v_max_f32_dpp v16, v14, v14 row_half_mirror row_mask:0xf bank_mask:0xf
    v_sub_f32 v18, v128, v16
    v_exp_f32 v18, v18
    v_readfirstlane_b32 s80, v16
    v_mul_f32 v19, v18, v129
    s_waitcnt lgkmcnt(0)
    v_mul_f32_dpp v64, v18, v130 row_newbcast:0 row_mask:0xf bank_mask:0xf
    v_add_f32_dpp v19, v19, v19 quad_perm:[1,0,3,2] row_mask:0xf bank_mask:0xf
    v_mul_f32_dpp v65, v18, v131 row_newbcast:0 row_mask:0xf bank_mask:0xf
    v_fmac_f32_dpp v64, v18, v132 row_newbcast:1 row_mask:0xf bank_mask:0xf
    v_add_f32_dpp v19, v19, v19 quad_perm:[2,3,0,1] row_mask:0xf bank_mask:0xf
    v_fmac_f32_dpp v65, v18, v133 row_newbcast:1 row_mask:0xf bank_mask:0xf
    v_fmac_f32_dpp v64, v18, v134 row_newbcast:2 row_mask:0xf bank_mask:0xf
    v_add_f32_dpp v19, v19, v19 row_half_mirror row_mask:0xf bank_mask:0xf
    v_fmac_f32_dpp v65, v18, v135 row_newbcast:2 row_mask:0xf bank_mask:0xf
    v_fmac_f32_dpp v64, v18, v136 row_newbcast:3 row_mask:0xf bank_mask:0xf
    v_fmac_f32_dpp v65, v18, v137 row_newbcast:3 row_mask:0xf bank_mask:0xf
    v_readfirstlane_b32 s81, v19
    v_readfirstlane_b32 s55, v13
    v_permlane32_swap_b32 v64, v65
    v_add_f32 v64, v64, v65
    v_cndmask_b32 v65, 0, 1, s[80:81]
    v_min_u32 v64, -4, v64
    s_cmp_eq_u32 s55, 0
    v_alignbit_b32 v64, v65, v64, 1
    s_cbranch_scc1 L_far
    buffer_store_dword v64, v11, s[20:23], s49 offen
    s_endpgm
L_far:
    s_or_b32 s49, s49, 8192
    s_lshl_b32 s55, 1, s48
    buffer_store_dword v64, v11, s[20:23], s49 offen sc1
    v_lshl_or_b32 v62, v0, 8, s47
    v_mov_b32 v13, s55
    s_cmp_eq_u32 s28, 0
    s_waitcnt vmcnt(0)
    s_barrier
    s_cbranch_scc0 L_end
    buffer_atomic_or v13, v62, s[24:27], 0 offen sc1
    s_endpgm
L_cons:
    s_cmp_eq_u32 s28, 4
    s_cbranch_scc1 L_touch
L_tback:
    s_waitcnt lgkmcnt(0)
    s_barrier
    buffer_load_dword v140, v11, s[20:23], s56 offen sc1
    buffer_load_dword v141, v11, s[20:23], s57 offen sc1
    buffer_load_dword v142, v11, s[20:23], s58 offen sc1
    ds_read_b64 v[128:129], v10
    ds_read_b64 v[130:131], v9 offset:0
    ds_read_b64 v[132:133], v9 offset:2304
    ds_read_b64 v[134:135], v9 offset:4608
    ds_read_b64 v[136:137], v9 offset:6912
    s_waitcnt lgkmcnt(4)
    v_max_f32_dpp v14, v128, v128 quad_perm:[1,0,3,2] row_mask:0xf bank_mask:0xf
    s_nop 1
    v_max_f32_dpp v14, v14, v14 quad_perm:[2,3,0,1] row_mask:0xf bank_mask:0xf
    s_nop 1
    v_max_f32_dpp v16, v14, v14 row_half_mirror row_mask:0xf bank_mask:0xf
    v_sub_f32 v18, v128, v16
    v_exp_f32 v18, v18
    s_nop 0
    v_mul_f32 v19, v18, v129
    s_waitcnt lgkmcnt(0)
    v_mul_f32_dpp v64, v18, v130 row_newbcast:0 row_mask:0xf bank_mask:0xf
    v_add_f32_dpp v19, v19, v19 quad_perm:[1,0,3,2] row_mask:0xf bank_mask:0xf
    v_mul_f32_dpp v65, v18, v131 row_newbcast:0 row_mask:0xf bank_mask:0xf
    v_fmac_f32_dpp v64, v18, v132 row_newbcast:1 row_mask:0xf bank_mask:0xf
    v_add_f32_dpp v19, v19, v19 quad_perm:[2,3,0,1] row_mask:0xf bank_mask:0xf
    v_fmac_f32_dpp v65, v18, v133 row_newbcast:1 row_mask:0xf bank_mask:0xf
    v_fmac_f32_dpp v64, v18, v134 row_newbcast:2 row_mask:0xf bank_mask:0xf
    v_add_f32_dpp v19, v19, v19 row_half_mirror row_mask:0xf bank_mask:0xf
    v_fmac_f32_dpp v65, v18, v135 row_newbcast:2 row_mask:0xf bank_mask:0xf
    v_fmac_f32_dpp v64, v18, v136 row_newbcast:3 row_mask:0xf bank_mask:0xf
    v_fmac_f32_dpp v65, v18, v137 row_newbcast:3 row_mask:0xf bank_mask:0xf
    s_nop 1
    v_permlane32_swap_b32 v64, v65
    v_add_f32 v64, v64, v65
L_ca:
    s_waitcnt vmcnt(0)
    v_max3_u32 v14, v140, v141, v142
    v_cmp_gt_i32 s[80:81], 0, v140
    v_cmp_eq_u32 vcc, -1, v14
    v_cmp_gt_i32 s[82:83], 0, v141
    v_cmp_gt_i32 s[84:85], 0, v142
    v_lshlrev_b32 v72, 1, v140
    v_lshlrev_b32 v73, 1, v141
    v_lshlrev_b32 v74, 1, v142
    s_cbranch_vccnz L_na
L_got:
    v_max_f32 v14, s80, v16
    v_max_f32 v15, s82, v16
    v_max3_f32 v14, s84, v14, v15
    v_sub_f32 v71, v16, v14
    v_sub_f32 v68, s80, v14
    v_sub_f32 v69, s82, v14
    v_sub_f32 v70, s84, v14
    v_exp_f32 v71, v71
    v_exp_f32 v68, v68
    v_exp_f32 v69, v69
    v_exp_f32 v70, v70
    v_mul_f32 v19, v19, v71
    v_mul_f32 v64, v64, v71
    v_mul_f32 v14, s83, v69
    v_fmac_f32 v19, s81, v68
    v_fmac_f32 v14, s85, v70
    v_fmac_f32 v64, v72, v68
    v_add_f32 v14, v14, v19
    v_mul_f32 v65, v73, v69
    v_rcp_f32 v14, v14
    v_fmac_f32 v64, v74, v70
    v_add_f32 v64, v64, v65
    v_mul_f32 v64, v64, v14
    v_cvt_pk_bf16_f32 v64, v64, v64
    buffer_store_short v64, v12, s[16:19], s44 offen
L_end:
    s_endpgm
L_na:
    s_sub_u32 s60, s60, 1
    s_cbranch_scc1 L_end
    s_and_b32 s55, s60, 15
    s_cbranch_scc0 L_word
    buffer_load_dword v140, v11, s[20:23], s56 offen sc1
    buffer_load_dword v141, v11, s[20:23], s57 offen sc1
    buffer_load_dword v142, v11, s[20:23], s58 offen sc1
    s_branch L_ca
L_word:
    v_mov_b32 v62, s47
    buffer_load_dword v13, v62, s[24:27], 0 offen sc1
    s_waitcnt vmcnt(0)
    v_readfirstlane_b32 s55, v13
    s_bitcmp1_b32 s55, 0
    s_cselect_b32 s61, 8192, 0
    s_or_b32 s56, s56, s61
    s_bitcmp1_b32 s55, 1
    s_cselect_b32 s61, 8192, 0
    s_or_b32 s57, s57, s61
    s_bitcmp1_b32 s55, 2
    s_cselect_b32 s61, 8192, 0
    s_or_b32 s58, s58, s61
    buffer_load_dword v140, v11, s[20:23], s56 offen sc1
    buffer_load_dword v141, v11, s[20:23], s57 offen sc1
    buffer_load_dword v142, v11, s[20:23], s58 offen sc1
    s_branch L_ca
L_side:
    s_cmp_eq_u32 s62, 2
    s_cbranch_scc0 L_tag
    v_mov_b32 v62, s47
    buffer_load_dword v13, v62, s[24:27], 0 offen sc1
    s_branch L_sback
L_tag:
    s_lshl_b32 s55, s63, 4
    v_lshl_or_b32 v62, v0, 8, s47
    v_mov_b32 v13, s55
    buffer_atomic_or v13, v62, s[24:27], 0 offen sc1
    s_branch L_sback
L_touch:
    v_lshlrev_b32 v60, 7, v0
    s_mov_b32 exec_hi, 0xffff
    buffer_load_dword v61, v60, s[20:23], s56 offen sc1
    s_mov_b32 exec_hi, -1
    s_branch L_tback
L_role:
    v_readfirstlane_b32 s55, v13
    v_lshlrev_b32 v20, 2, v0
    s_lshr_b32 s55, s55, 4
    s_cmp_eq_u32 s55, s63
    s_cselect_b32 s55, 1, 0
    v_mov_b32 v21, s55
    ds_write_b32 v20, v21 offset:18688
    s_branch L_back
.section .rodata,"a"
.p2align 6
.amdhsa_kernel standalone__gqa_softmax__sampling_kernel
  .amdhsa_next_free_vgpr 192
  .amdhsa_next_free_sgpr 96
  .amdhsa_accum_offset 192
  .amdhsa_group_segment_fixed_size 0
  .amdhsa_kernarg_size 48
  .amdhsa_user_sgpr_count 2
  .amdhsa_user_sgpr_kernarg_segment_ptr 1
  .amdhsa_system_sgpr_workgroup_id_x 1
.end_amdhsa_kernel
```
